```python
import torch

def _softmax(x, axis=-1):
    return torch.softmax(x, dim=axis)
def _gelu(x):
    return torch.nn.functional.gelu(x, approximate="tanh")
def _silu(x):
    return torch.nn.functional.silu(x)
def _sigmoid(x):
    return torch.sigmoid(x)
def _layernorm(x, axis=-1, eps=1e-5):
    m = x.mean(dim=axis, keepdim=True)
    v = x.var(dim=axis, keepdim=True, unbiased=False)
    return (x - m) / torch.sqrt(v + eps)
def _scatter_add(tgt, idx, src, axis=0):
    return tgt.clone().index_add_(axis, idx, src)
def _segment_sum(src, seg, n):
    out = torch.zeros((n,) + src.shape[1:], dtype=src.dtype)
    return out.index_add_(0, seg, src)
def _pad(x, pw):
    flat = tuple(v for pair in reversed(pw) for v in pair)
    return torch.nn.functional.pad(x, flat)

kernel_name = 'interleave_layers__sliding_block_cached__glu_gated_glu__decode'

def setup_inputs():

    _w = (lambda a: (lambda t: t.to(torch.bfloat16) if t.is_floating_point() else t)(torch.as_tensor(a)))
    def _A_setup():
        B, Sq, D = 2, 1, 512
        Hq, Hkv, Sk, Dh = 32, 8, 32768, 128
        assert Hq % Hkv == 0, (Hq, Hkv)
        return {
            "x": _w((lambda *s: torch.randn(*s, dtype=torch.bfloat16) * 0.05)(B, Sq, D)),
            "k_cache": _w((lambda *s: torch.randn(*s, dtype=torch.bfloat16) * 1.6)(B, Hkv, Sk, Dh)),
            "v_cache": _w((lambda *s: torch.randn(*s, dtype=torch.bfloat16) * 1.6)(B, Hkv, Sk, Dh)),
            "wq": _w((lambda *s: torch.randn(*s, dtype=torch.bfloat16) * 1.6)(D, Hq * Dh) * (D ** -0.5)),
            "wo": _w((lambda *s: torch.randn(*s, dtype=torch.bfloat16) * 1.6)(Hq * Dh, D) * ((Hq * Dh) ** -0.5)),
        }
    _A_in = _A_setup()

    def _B_setup():
        B, S, D, F = 2, 1, 512, 1792
        return {
            "x": _w((lambda *s: torch.randn(*s, dtype=torch.bfloat16) * 0.05)(B, S, D)),
            "w_gate": _w((lambda *s: torch.randn(*s, dtype=torch.bfloat16) * 0.05)(D, F)),
            "w_up": _w((lambda *s: torch.randn(*s, dtype=torch.bfloat16) * 0.05)(D, F)),
            "w_down": _w((lambda *s: torch.randn(*s, dtype=torch.bfloat16) * 0.05)(F, D)),
        }
    _B_in = _B_setup()

    return {
        "A_x": _A_in["x"],
        "A_k_cache": _A_in["k_cache"],
        "A_v_cache": _A_in["v_cache"],
        "A_wq": _A_in["wq"],
        "A_wo": _A_in["wo"],
        "B_x": _B_in["x"],
        "B_w_gate": _B_in["w_gate"],
        "B_w_up": _B_in["w_up"],
        "B_w_down": _B_in["w_down"],
    }

def reference(A_x, A_k_cache, A_v_cache, A_wq, A_wo, B_x, B_w_gate, B_w_up, B_w_down):
    def _A_ref(x, k_cache, v_cache, wq, wo):
        B, Sq, D = x.shape
        Hq, Dh = 32, 128
        Hkv, Sk = k_cache.shape[1], k_cache.shape[2]
        W = min(4096, max(256, Sk // 4))
        rep = Hq // Hkv
        q = (lambda x, *d: x.permute(*d))((x @ wq).reshape(B, Sq, Hq, Dh), 0, 2, 1, 3)
        k = (lambda x, n, axis: torch.repeat_interleave(x, n, dim=axis))(k_cache[:, :, Sk - W:, :], rep, axis=1)
        v = (lambda x, n, axis: torch.repeat_interleave(x, n, dim=axis))(v_cache[:, :, Sk - W:, :], rep, axis=1)
        scores = torch.einsum("bhqd,bhkd->bhqk", q, k) * (Dh ** -0.5)
        p = _softmax(scores, axis=-1)
        o = torch.einsum("bhqk,bhkd->bhqd", p, v)
        return (lambda x, *d: x.permute(*d))(o, 0, 2, 1, 3).reshape(B, Sq, Hq * Dh) @ wo

    def _B_ref(x, w_gate, w_up, w_down):
        g = torch.einsum("bsd,df->bsf", x, w_gate)
        u = torch.einsum("bsd,df->bsf", x, w_up)
        h = _sigmoid(g) * u
        return torch.einsum("bsf,fd->bsd", h, w_down)

    x = A_x
    x = x + _A_ref(_layernorm(x, axis=-1), A_k_cache, A_v_cache, A_wq, A_wo)
    x = x + _B_ref(_layernorm(x, axis=-1), B_w_gate, B_w_up, B_w_down)
    x = x + _A_ref(_layernorm(x, axis=-1), A_k_cache, A_v_cache, A_wq, A_wo)
    x = x + _B_ref(_layernorm(x, axis=-1), B_w_gate, B_w_up, B_w_down)
    return x
```

```asm
; @launch grid=(256,1,1) block=(512,1,1) lds=159744
.amdgcn_target "amdgcn-amd-amdhsa--gfx950"
.text
.globl interleave_layers__sliding_block_cached__glu_gated_glu__decode_kernel
.p2align 8
.type interleave_layers__sliding_block_cached__glu_gated_glu__decode_kernel,@function
interleave_layers__sliding_block_cached__glu_gated_glu__decode_kernel:
    s_cmp_ge_u32 s2, 256
    s_cbranch_scc1 L_end
    s_load_dwordx16 s[8:23], s[0:1], 0
    s_load_dwordx8 s[24:31], s[0:1], 64
    s_getpc_b64 s[74:75]
L_pc:
    s_sub_u32 s74, s74, L_pc-interleave_layers__sliding_block_cached__glu_gated_glu__decode_kernel
    s_subb_u32 s75, s75, 0
    s_lshr_b32 s76, s2, 3
    s_and_b32 s76, s76, 1
    s_lshl_b32 s76, s76, 13
    v_lshlrev_b32 v126, 7, v0
    v_add_u32 v126, s76, v126
    v_min_u32 v126, L_end-interleave_layers__sliding_block_cached__glu_gated_glu__decode_kernel, v126
    v_cmp_gt_u32 vcc, 64, v0
    s_nop 0
    s_and_saveexec_b64 s[76:77], vcc
    s_cbranch_execz L_cpf_done
    global_load_dword v127, v126, s[74:75]
L_cpf_done:
    s_mov_b64 exec, s[76:77]
    v_lshrrev_b32 v44, 6, v0
    v_and_b32 v1, 63, v0
    v_and_b32 v2, 15, v0
    v_readfirstlane_b32 s3, v44
    v_lshrrev_b32 v3, 4, v1
    s_and_b32 s4, s2, 7
    s_lshr_b32 s5, s2, 3
    s_lshr_b32 s6, s5, 4
    s_and_b32 s7, s5, 15
    s_lshl_b32 s95, s6, 3
    s_add_u32 s95, s95, s4
    s_mov_b32 s82, 4096
    s_mov_b32 s72, 0
    v_lshrrev_b32 v44, 2, v1
    v_and_b32 v45, 3, v1
    v_lshrrev_b32 v46, 5, v1
    v_lshlrev_b32 v46, 1, v46
    v_xor_b32 v45, v45, v46
    v_lshlrev_b32 v45, 4, v45
    s_lshl_b32 s84, s3, 6
    v_add_u32 v46, s84, v44
    v_lshl_add_u32 v37, v46, 13, v45
    v_lshl_add_u32 v38, v46, 10, v45
    s_mov_b32 s85, 3584
    v_mul_lo_u32 v47, v46, s85
    v_add_u32 v39, v47, v45
    s_lshl_b32 s84, s3, 5
    v_add_u32 v46, s84, v44
    v_lshl_add_u32 v40, v46, 10, v45
    v_lshlrev_b32 v48, 1, v0
    s_waitcnt lgkmcnt(0)
    s_lshl_b32 s84, s6, 10
    s_add_u32 s68, s8, s84
    s_addc_u32 s69, s9, 0
    s_mov_b32 s70, 1024
    s_mov_b32 s71, 0x20000
    s_lshl_b32 s84, s4, 10
    s_lshl_b32 s85, s7, 6
    s_add_u32 s84, s84, s85
    s_add_u32 s40, s14, s84
    s_addc_u32 s41, s15, 0
    s_sub_u32 s42, 4194304, s84
    s_mov_b32 s43, 0x20000
    buffer_load_ushort v29, v48, s[68:71], 0 offen
    s_cmp_lg_u32 s3, 1
    s_cbranch_scc1 L_pf3_1
    s_mov_b32 s68, s14
    s_mov_b32 s69, s15
    s_mov_b32 s70, 4194304
    s_mov_b32 s71, 0x20000
    v_and_b32 v104, 15, v1
    s_lshl_b32 s84, s5, 4
    v_add_u32 v104, s84, v104
    v_lshlrev_b32 v104, 13, v104
    s_lshl_b32 s84, s4, 10
    s_add_u32 s84, s84, 384
    v_lshrrev_b32 v105, 4, v1
    v_and_b32 v105, 1, v105
    v_lshl_add_u32 v104, v105, 6, v104
    s_mov_b32 exec_hi, 0
    buffer_load_dword v85, v104, s[68:71], s84 offen
    s_mov_b32 exec_hi, -1
L_pf3_1:
    s_lshl_b32 s84, s3, 13
    s_add_u32 m0, s84, 65536
    s_nop 0
    buffer_load_dwordx4 v37, s[40:43], 0 offen offset:0 nt lds
    s_mov_b32 s85, 130048
    buffer_load_dwordx4 v37, s[40:43], s85 offen offset:1024 nt lds
    s_mov_b32 s85, 260096
    buffer_load_dwordx4 v37, s[40:43], s85 offen offset:2048 nt lds
    s_mov_b32 s85, 390144
    buffer_load_dwordx4 v37, s[40:43], s85 offen offset:3072 nt lds
    s_lshl_b32 s84, s95, 23
    s_lshl_b32 s85, s7, 16
    s_add_u32 s84, s84, s85
    s_add_u32 s84, s84, 7340032
    s_add_u32 s36, s12, s84
    s_addc_u32 s37, s13, 0
    s_mov_b32 s38, 65536
    s_mov_b32 s39, 0x20000
    s_add_u32 s32, s10, s84
    s_addc_u32 s33, s11, 0
    s_mov_b32 s34, 65536
    s_mov_b32 s35, 0x20000
    s_mov_b32 s56, s30
    s_mov_b32 s57, s31
    s_mov_b32 s58, 0x20000000
    s_mov_b32 s59, 0x20000
    s_lshl_b32 s84, s3, 13
    v_lshlrev_b32 v44, 8, v2
    v_lshl_add_u32 v44, v3, 4, v44
    v_add_u32 v34, s84, v44
    v_lshlrev_b32 v44, 1, v3
    v_xor_b32 v44, v44, v2
    v_lshlrev_b32 v44, 4, v44
    v_lshl_add_u32 v35, v3, 8, v44
    v_xor_b32 v36, 128, v35
    s_add_u32 s92, s3, s7
    s_and_b32 s92, s92, 3
    s_lshl_b32 s92, s92, 1
    s_lshl_b32 s93, s3, 13
    s_barrier
    s_cmp_eq_u32 s3, 0
    s_cbranch_scc1 L_proto
    s_cmp_lg_u32 s3, 7
    s_cbranch_scc1 L_va
    s_lshl_b32 s84, s6, 7
    s_add_u32 s84, s84, 921600
    v_mov_b32 v74, s84
    buffer_load_dword v74, v74, s[56:59], 0 offen sc1
L_va:
    s_add_u32 s92, s3, s7
    s_and_b32 s92, s92, 3
    s_lshl_b32 s92, s92, 1
    s_lshl_b32 s93, s3, 13
    s_add_u32 s84, s92, 0
    s_and_b32 s84, s84, 7
    s_lshl_b32 s84, s84, 10
    s_add_u32 s84, s84, s93
    s_add_u32 m0, s84, 0
    s_nop 0
    buffer_load_dwordx4 v35, s[36:39], s84 offen nt lds
    s_add_u32 s84, s92, 1
    s_and_b32 s84, s84, 7
    s_lshl_b32 s84, s84, 10
    s_add_u32 s84, s84, s93
    s_add_u32 m0, s84, 0
    s_nop 0
    buffer_load_dwordx4 v36, s[36:39], s84 offen nt lds
    s_add_u32 s84, s92, 2
    s_and_b32 s84, s84, 7
    s_lshl_b32 s84, s84, 10
    s_add_u32 s84, s84, s93
    s_add_u32 m0, s84, 0
    s_nop 0
    buffer_load_dwordx4 v35, s[36:39], s84 offen nt lds
    s_add_u32 s84, s92, 3
    s_and_b32 s84, s84, 7
    s_lshl_b32 s84, s84, 10
    s_add_u32 s84, s84, s93
    s_add_u32 m0, s84, 0
    s_nop 0
    buffer_load_dwordx4 v36, s[36:39], s84 offen nt lds
    s_add_u32 s84, s92, 4
    s_and_b32 s84, s84, 7
    s_lshl_b32 s84, s84, 10
    s_add_u32 s84, s84, s93
    s_add_u32 m0, s84, 0
    s_nop 0
    buffer_load_dwordx4 v35, s[36:39], s84 offen nt lds
    s_branch L_pre_p1
L_proto:
    s_lshl_b32 s84, s6, 7
    s_add_u32 s84, s84, 921600
    v_mov_b32 v74, s84
    buffer_load_dword v74, v74, s[56:59], 0 offen sc1
    s_mul_i32 s84, s95, 49152
    s_mul_i32 s85, s7, 3072
    s_add_u32 s84, s84, s85
    v_lshl_add_u32 v44, v1, 4, s84
    v_mov_b32 v48, -1
    v_mov_b32 v49, -1
    v_mov_b32 v50, -1
    v_mov_b32 v51, -1
    buffer_store_dwordx4 v[48:51], v44, s[56:59], 0 offen sc1
    buffer_store_dwordx4 v[48:51], v44, s[56:59], 0 offen offset:1024 sc1
    buffer_store_dwordx4 v[48:51], v44, s[56:59], 0 offen offset:2048 sc1
    s_lshl_b32 s84, s6, 13
    s_lshr_b32 s85, s7, 1
    s_lshl_b32 s85, s85, 10
    s_add_u32 s84, s84, s85
    s_lshl_b32 s85, s4, 7
    s_add_u32 s84, s84, s85
    s_and_b32 s85, s7, 1
    s_lshl_b32 s85, s85, 6
    s_add_u32 s84, s84, s85
    s_add_u32 s84, s84, 786432
    v_lshrrev_b32 v45, 2, v1
    v_lshlrev_b32 v45, 14, v45
    v_and_b32 v46, 3, v1
    v_lshl_add_u32 v45, v46, 4, v45
    v_add_u32 v45, s84, v45
    s_mov_b64 exec, 0xffff
    buffer_store_dwordx4 v[48:51], v45, s[56:59], 0 offen sc1
    s_mov_b64 exec, -1
L_pre_p1:
    s_getreg_b32 s61, hwreg(HW_REG_XCC_ID, 0, 4)
    v_lshlrev_b32 v4, 1, v0
    v_add_u32 v4, 131072, v4
    s_lshl_b32 s84, s3, 7
    v_lshl_add_u32 v5, v3, 4, s84
    v_add_u32 v5, 131072, v5
    v_cmp_eq_u32 vcc, 0, v2
    v_mov_b32 v44, 132096
    s_lshl_b32 s85, s3, 3
    v_cndmask_b32 v5, v44, v5, vcc
    s_lshl_b32 s92, s3, 2
    s_add_u32 s92, s92, 135424
    v_mov_b32 v6, s92
    v_min_u32 v44, 33, v1
    v_mul_u32_u24 v44, 48, v44
    v_add_u32 v7, 133888, v44
    s_lshl_b32 s84, s3, 8
    v_lshlrev_b32 v44, 6, v2
    v_lshl_add_u32 v44, v3, 4, v44
    v_add_u32 v44, s84, v44
    v_add_u32 v18, 135936, v44
    v_lshrrev_b32 v44, 2, v2
    v_lshlrev_b32 v44, 6, v44
    v_lshl_add_u32 v44, v3, 4, v44
    v_add_u32 v19, 135936, v44
    v_lshlrev_b32 v44, 6, v2
    v_add_u32 v44, s85, v44
    v_add_u32 v20, 137984, v44
    v_lshlrev_b32 v44, 6, v3
    v_add_u32 v21, 137984, v44
    v_and_b32 v44, 7, v2
    v_lshl_add_u32 v21, v44, 3, v21
    v_lshrrev_b32 v44, 5, v1
    v_lshl_add_u32 v44, v44, 4, v2
    v_mul_u32_u24 v44, 48, v44
    s_lshl_b32 s84, s3, 2
    v_add_u32 v44, s84, v44
    v_add_u32 v22, 138240, v44
    v_and_b32 v45, 31, v1
    v_mul_u32_u24 v44, 48, v45
    v_add_u32 v23, 138240, v44
    v_add_u32 v27, 140288, v44
    v_mul_u32_u24 v44, 48, v2
    v_add_u32 v44, s84, v44
    v_add_u32 v26, 140288, v44
    s_lshl_b32 s84, s3, 6
    v_lshl_add_u32 v44, v45, 1, s84
    v_add_u32 v24, 139776, v44
    v_lshl_add_u32 v44, v3, 4, s84
    v_add_u32 v25, 139776, v44
    v_and_b32 v44, 1, v1
    v_lshlrev_b32 v44, 4, v44
    v_sub_u32 v28, 16, v44
    v_lshrrev_b32 v44, 2, v2
    v_lshl_add_u32 v44, v3, 3, v44
    v_lshlrev_b32 v44, 6, v44
    v_and_b32 v46, 3, v2
    v_lshrrev_b32 v47, 1, v46
    v_and_b32 v48, 1, v3
    v_lshlrev_b32 v48, 1, v48
    v_xor_b32 v47, v47, v48
    v_lshl_add_u32 v44, v47, 4, v44
    v_and_b32 v47, 1, v46
    v_lshl_add_u32 v44, v47, 3, v44
    s_lshl_b32 s84, s3, 13
    s_add_u32 s84, s84, 65536
    v_add_u32 v31, s84, v44
    v_xor_b32 v32, 32, v31
    v_lshrrev_b32 v44, 2, v2
    v_lshl_add_u32 v47, v3, 2, v44
    v_lshlrev_b32 v47, 8, v47
    v_and_b32 v48, 1, v3
    v_lshlrev_b32 v48, 2, v48
    v_add_u32 v48, v48, v44
    v_lshlrev_b32 v48, 1, v48
    v_lshrrev_b32 v49, 1, v46
    s_lshl_b32 s84, s3, 1
    v_add_u32 v49, s84, v49
    v_xor_b32 v49, v49, v48
    v_lshl_add_u32 v47, v49, 4, v47
    v_and_b32 v49, 1, v46
    v_lshl_add_u32 v33, v49, 3, v47
    s_lshl_b32 s84, s3, 11
    v_and_b32 v44, 7, v2
    v_xor_b32 v44, v44, v3
    v_lshlrev_b32 v44, 4, v44
    v_lshl_add_u32 v44, v2, 7, v44
    v_add_u32 v44, s84, v44
    v_add_u32 v41, 0, v44
    v_xor_b32 v42, 64, v41
    v_and_b32 v44, 3, v2
    v_mul_u32_u24 v44, 320, v44
    v_lshl_add_u32 v44, v3, 4, v44
    v_add_u32 v43, 141952, v44
    s_lshl_b32 s84, s6, 13
    s_lshl_b32 s85, s3, 10
    s_add_u32 s85, s85, s84
    s_add_u32 s85, s85, 786432
    v_and_b32 v44, 7, v2
    v_lshlrev_b32 v44, 7, v44
    v_lshrrev_b32 v45, 3, v2
    v_lshl_add_u32 v44, v45, 6, v44
    v_lshl_add_u32 v44, v3, 4, v44
    v_add_u32 v8, s85, v44
    s_lshr_b32 s85, s7, 1
    s_lshl_b32 s85, s85, 10
    s_add_u32 s84, s84, s85
    s_lshl_b32 s85, s4, 7
    s_add_u32 s84, s84, s85
    s_and_b32 s85, s7, 1
    s_lshl_b32 s85, s85, 6
    s_add_u32 s84, s84, s85
    s_add_u32 s84, s84, 786432
    v_lshl_add_u32 v9, v1, 1, s84
    s_mul_i32 s84, s95, 49152
    s_add_u32 s85, s84, 1024
    v_lshl_add_u32 v10, v1, 4, s85
    s_lshl_b32 s92, s7, 6
    s_add_u32 s85, s85, s92
    v_lshl_add_u32 v11, v1, 1, s85
    s_lshl_b32 s85, s7, 6
    s_add_u32 s92, s85, 64
    s_cmp_lt_u32 s7, 7
    s_cselect_b32 s85, s85, s92
    s_add_u32 s85, s85, s84
    s_add_u32 s85, s85, 2048
    v_lshl_add_u32 v12, v1, 1, s85
    v_and_b32 v44, 30, v1
    v_lshlrev_b32 v44, 1, v44
    s_lshl_b32 s85, s3, 6
    s_add_u32 s85, s85, s84
    s_add_u32 s85, s85, 2048
    v_add_u32 v13, s85, v44
    s_add_u32 s84, s84, 8192
    s_lshl_b32 s85, s7, 10
    s_add_u32 s85, s85, s84
    s_lshl_b32 s92, s3, 5
    s_add_u32 s85, s85, s92
    v_lshlrev_b32 v44, 8, v3
    v_lshl_add_u32 v44, v2, 1, v44
    v_add_u32 v14, s85, v44
    s_lshl_b32 s92, s3, 7
    s_add_u32 s85, s84, s92
    v_lshrrev_b32 v44, 3, v1
    v_and_b32 v45, 7, v1
    v_xor_b32 v45, v45, v44
    v_lshlrev_b32 v44, 10, v44
    v_lshl_add_u32 v44, v45, 4, v44
    v_add_u32 v15, s85, v44
    s_mul_i32 s84, s95, 49152
    s_add_u32 s84, s84, 4096
    s_lshl_b32 s85, s7, 3
    s_add_u32 s85, s85, s84
    v_lshl_add_u32 v16, v3, 7, s85
    s_lshr_b32 s85, s3, 1
    s_lshl_b32 s85, s85, 7
    s_add_u32 s85, s85, s84
    v_lshl_add_u32 v17, v3, 5, s85
    s_mov_b32 s86, 0x000f000f
    s_mov_b32 s87, 0x000f000f
    s_mov_b32 s88, 0x55555555
    s_mov_b32 s89, 0x55555555
    s_mov_b32 s90, 0x00010001
    s_mov_b32 s91, 0x00010001
    s_mov_b32 s83, 0x3e0293ee
    s_mov_b32 s94, 0xbfb8aa3b
    s_mov_b32 s76, 0
    s_mov_b32 s77, 0
    s_mov_b32 s78, 0
    s_mov_b32 s79, 0x8000
    s_mov_b32 s63, 0x8000
    s_mov_b32 s100, -1
    s_mov_b32 s101, 0
    s_mov_b32 s80, 0
    s_mov_b32 s62, 7168
    s_mov_b32 s81, 0
    s_mov_b32 s73, 0
    s_lshl_b32 s84, s4, 19
    s_lshl_b32 s85, s7, 6
    s_add_u32 s84, s84, s85
    s_add_u32 s44, s16, s84
    s_addc_u32 s45, s17, 0
    s_sub_u32 s46, 4194304, s84
    s_mov_b32 s47, 0x20000
    s_mul_i32 s84, s4, 229376
    s_add_u32 s84, s84, s85
    s_add_u32 s52, s24, s84
    s_addc_u32 s53, s25, 0
    s_sub_u32 s54, 1835008, s84
    s_mov_b32 s55, 0x20000
    s_mul_i32 s84, s4, 448
    s_sub_u32 s92, s85, 448
    s_cmp_lt_u32 s7, 7
    s_cselect_b32 s85, s85, s92
    s_cselect_b32 s92, s20, s22
    s_cselect_b32 s93, s21, s23
    s_add_u32 s84, s84, s85
    s_add_u32 s48, s92, s84
    s_addc_u32 s49, s93, 0
    s_sub_u32 s50, 1835008, s84
    s_mov_b32 s51, 0x20000
    s_mov_b32 s64, s26
    s_mov_b32 s65, s27
    s_mov_b32 s66, 2048
    s_mov_b32 s67, 0x20000
    v_mov_b32 v44, 0
    v_and_b32 v45, 31, v1
    v_lshlrev_b32 v45, 2, v45
    v_add_u32 v45, 132096, v45
    ds_write_b32 v45, v44
    v_mov_b32 v44, 0x3f80
    v_lshlrev_b32 v45, 3, v3
    v_sub_u32 v45, v2, v45
    v_add_u32 v46, 16, v45
    v_mov_b32 v47, 0x3f800000
    v_cmp_eq_u32 vcc, 0, v45
    v_mov_b32 v248, 0
    s_nop 0
    v_cndmask_b32 v248, v248, v44, vcc
    v_cmp_eq_u32 vcc, 1, v45
    s_nop 1
    v_cndmask_b32 v248, v248, v47, vcc
    v_cmp_eq_u32 vcc, 2, v45
    v_mov_b32 v249, 0
    s_nop 0
    v_cndmask_b32 v249, v249, v44, vcc
    v_cmp_eq_u32 vcc, 3, v45
    s_nop 1
    v_cndmask_b32 v249, v249, v47, vcc
    v_cmp_eq_u32 vcc, 4, v45
    v_mov_b32 v250, 0
    s_nop 0
    v_cndmask_b32 v250, v250, v44, vcc
    v_cmp_eq_u32 vcc, 5, v45
    s_nop 1
    v_cndmask_b32 v250, v250, v47, vcc
    v_cmp_eq_u32 vcc, 6, v45
    v_mov_b32 v251, 0
    s_nop 0
    v_cndmask_b32 v251, v251, v44, vcc
    v_cmp_eq_u32 vcc, 7, v45
    s_nop 1
    v_cndmask_b32 v251, v251, v47, vcc
    v_cmp_eq_u32 vcc, 0, v46
    v_mov_b32 v252, 0
    s_nop 0
    v_cndmask_b32 v252, v252, v44, vcc
    v_cmp_eq_u32 vcc, 1, v46
    s_nop 1
    v_cndmask_b32 v252, v252, v47, vcc
    v_cmp_eq_u32 vcc, 2, v46
    v_mov_b32 v253, 0
    s_nop 0
    v_cndmask_b32 v253, v253, v44, vcc
    v_cmp_eq_u32 vcc, 3, v46
    s_nop 1
    v_cndmask_b32 v253, v253, v47, vcc
    v_cmp_eq_u32 vcc, 4, v46
    v_mov_b32 v254, 0
    s_nop 0
    v_cndmask_b32 v254, v254, v44, vcc
    v_cmp_eq_u32 vcc, 5, v46
    s_nop 1
    v_cndmask_b32 v254, v254, v47, vcc
    v_cmp_eq_u32 vcc, 6, v46
    v_mov_b32 v255, 0
    s_nop 0
    v_cndmask_b32 v255, v255, v44, vcc
    v_cmp_eq_u32 vcc, 7, v46
    s_nop 1
    v_cndmask_b32 v255, v255, v47, vcc
    s_cmp_eq_u32 s3, 0
    s_cbranch_scc1 L_wq_w0
    s_waitcnt vmcnt(5)
    v_add_u32 v74, 2654435769, v74
    s_nop 0
    v_readfirstlane_b32 s60, v74
    s_branch L_wq_landed
L_wq_w0:
    s_waitcnt vmcnt(0)
    v_add_u32 v74, 2654435769, v74
    s_nop 0
    v_readfirstlane_b32 s60, v74
    s_lshl_b32 s84, s95, 7
    s_lshl_b32 s92, s7, 2
    s_add_u32 s84, s84, s92
    s_add_u32 s84, s84, 917504
    v_mov_b32 v52, s84
    v_add_u32 v53, s61, v74
    s_mov_b64 exec, 1
    buffer_store_dword v53, v52, s[56:59], 0 offen sc1
    s_mov_b64 exec, -1
    s_add_u32 s92, s3, s7
    s_and_b32 s92, s92, 3
    s_lshl_b32 s92, s92, 1
    s_lshl_b32 s93, s3, 13
    s_add_u32 s84, s92, 0
    s_and_b32 s84, s84, 7
    s_lshl_b32 s84, s84, 10
    s_add_u32 s84, s84, s93
    s_add_u32 m0, s84, 0
    s_nop 0
    buffer_load_dwordx4 v35, s[36:39], s84 offen nt lds
    s_add_u32 s84, s92, 1
    s_and_b32 s84, s84, 7
    s_lshl_b32 s84, s84, 10
    s_add_u32 s84, s84, s93
    s_add_u32 m0, s84, 0
    s_nop 0
    buffer_load_dwordx4 v36, s[36:39], s84 offen nt lds
    s_add_u32 s84, s92, 2
    s_and_b32 s84, s84, 7
    s_lshl_b32 s84, s84, 10
    s_add_u32 s84, s84, s93
    s_add_u32 m0, s84, 0
    s_nop 0
    buffer_load_dwordx4 v35, s[36:39], s84 offen nt lds
    s_add_u32 s84, s92, 3
    s_and_b32 s84, s84, 7
    s_lshl_b32 s84, s84, 10
    s_add_u32 s84, s84, s93
    s_add_u32 m0, s84, 0
    s_nop 0
    buffer_load_dwordx4 v36, s[36:39], s84 offen nt lds
    s_add_u32 s84, s92, 4
    s_and_b32 s84, s84, 7
    s_lshl_b32 s84, s84, 10
    s_add_u32 s84, s84, s93
    s_add_u32 m0, s84, 0
    s_nop 0
    buffer_load_dwordx4 v35, s[36:39], s84 offen nt lds
L_wq_landed:
    ds_read_b64_tr_b16 v[192:193], v31 offset:0
    ds_read_b64_tr_b16 v[194:195], v31 offset:256
    ds_read_b64_tr_b16 v[196:197], v32 offset:0
    ds_read_b64_tr_b16 v[198:199], v32 offset:256
    ds_read_b64_tr_b16 v[200:201], v31 offset:2048
    ds_read_b64_tr_b16 v[202:203], v31 offset:2304
    ds_read_b64_tr_b16 v[204:205], v32 offset:2048
    ds_read_b64_tr_b16 v[206:207], v32 offset:2304
    v_lshlrev_b32 v29, 16, v29
    v_lshrrev_b32 v80, 16, v29
    ds_write_b16 v4, v80
    v_mov_b32 v68, 0
    v_mov_b32 v69, 0
    v_mov_b32 v70, 0
    v_mov_b32 v71, 0
    s_waitcnt lgkmcnt(0)
    ds_read_b128 v[44:47], v5
    ds_read_b128 v[48:51], v5 offset:64
    s_waitcnt lgkmcnt(0)
    v_mfma_f32_16x16x32_bf16 v[52:55], v[44:47], v[192:195], 0
    v_mfma_f32_16x16x32_bf16 v[56:59], v[44:47], v[196:199], 0
    v_mfma_f32_16x16x32_bf16 v[52:55], v[48:51], v[200:203], v[52:55]
    v_mfma_f32_16x16x32_bf16 v[56:59], v[48:51], v[204:207], v[56:59]
    s_cmp_lg_u32 s72, 0
    s_cbranch_scc1 L_cs_2
    v_mov_b32 v84, 0x3f803f80
    v_mov_b32 v85, 0x3f803f80
    v_mov_b32 v86, 0x3f803f80
    v_mov_b32 v87, 0x3f803f80
    s_nop 1
    v_mfma_f32_16x16x32_bf16 v[88:91], v[84:87], v[192:195], 0
    v_mfma_f32_16x16x32_bf16 v[92:95], v[84:87], v[196:199], 0
    v_mfma_f32_16x16x32_bf16 v[88:91], v[84:87], v[200:203], v[88:91]
    v_mfma_f32_16x16x32_bf16 v[92:95], v[84:87], v[204:207], v[92:95]
    s_nop 7
    v_cndmask_b32 v88, v92, v88, s[100:101]
    s_mov_b32 exec_lo, 0xffff
    s_mov_b32 exec_hi, 0xffff
    v_add_u32 v89, 4294961408, v22
    ds_write_b32 v89, v88
    s_mov_b64 exec, -1
L_cs_2:
    s_branch L_p1_post
L_layer:
    ds_read_b128 v[44:47], v5
    ds_read_b128 v[48:51], v5 offset:64
    s_waitcnt lgkmcnt(0)
    v_mfma_f32_16x16x32_bf16 v[52:55], v[44:47], v[192:195], 0
    v_mfma_f32_16x16x32_bf16 v[56:59], v[44:47], v[196:199], 0
    v_mfma_f32_16x16x32_bf16 v[52:55], v[48:51], v[200:203], v[52:55]
    v_mfma_f32_16x16x32_bf16 v[56:59], v[48:51], v[204:207], v[56:59]
    s_cmp_lg_u32 s72, 0
    s_cbranch_scc1 L_cs_3
    v_mov_b32 v84, 0x3f803f80
    v_mov_b32 v85, 0x3f803f80
    v_mov_b32 v86, 0x3f803f80
    v_mov_b32 v87, 0x3f803f80
    s_nop 1
    v_mfma_f32_16x16x32_bf16 v[88:91], v[84:87], v[192:195], 0
    v_mfma_f32_16x16x32_bf16 v[92:95], v[84:87], v[196:199], 0
    v_mfma_f32_16x16x32_bf16 v[88:91], v[84:87], v[200:203], v[88:91]
    v_mfma_f32_16x16x32_bf16 v[92:95], v[84:87], v[204:207], v[92:95]
    s_nop 7
    v_cndmask_b32 v88, v92, v88, s[100:101]
    s_mov_b32 exec_lo, 0xffff
    s_mov_b32 exec_hi, 0xffff
    v_add_u32 v89, 4294961408, v22
    ds_write_b32 v89, v88
    s_mov_b64 exec, -1
L_cs_3:
    buffer_load_dwordx4 v[68:71], v8, s[56:59], s63 offen sc1
    s_waitcnt vmcnt(0)
L_pd_c_6:
    v_max3_u32 v84, v68, v69, v70
    v_max_u32 v84, v84, v71
    v_cmp_eq_u32 vcc, -1, v84
    s_cbranch_vccz L_pd_ok_5
    s_add_u32 s81, s81, 1
    s_cmp_lt_u32 s81, 1048576
    s_cbranch_scc1 L_pd_r_4
    s_branch L_bail
L_pd_r_4:
    buffer_load_dwordx4 v[68:71], v8, s[56:59], s63 offen sc1
    s_waitcnt vmcnt(0)
    s_branch L_pd_c_6
L_pd_ok_5:
L_p1_post:
    v_mfma_f32_16x16x32_bf16 v[72:75], v[68:71], v[248:251], 0
    v_mfma_f32_16x16x32_bf16 v[76:79], v[68:71], v[252:255], 0
    v_mfma_f32_16x16x32_bf16 v[52:55], v[68:71], v[192:195], v[52:55]
    v_mfma_f32_16x16x32_bf16 v[56:59], v[68:71], v[196:199], v[56:59]
    v_mfma_f32_16x16x32_bf16 v[60:63], v[68:71], v[200:203], 0
    v_mfma_f32_16x16x32_bf16 v[64:67], v[68:71], v[204:207], 0
    s_nop 2
    v_add_f32 v72, v72, v73
    v_add_f32 v74, v74, v75
    v_add_f32 v76, v76, v77
    v_add_f32 v78, v78, v79
    v_add_f32 v72, v72, v74
    v_add_f32 v76, v76, v78
    s_nop 1
    v_permlane16_swap_b32 v72, v76
    v_add_f32 v72, v72, v76
    v_cvt_pk_bf16_f32 v72, v72, v72
    v_and_b32 v72, 0xffff0000, v72
    v_add_f32 v29, v29, v72
    v_cvt_pk_bf16_f32 v80, v29, v29
    v_and_b32 v29, 0xffff0000, v80
    ds_write_b16 v4, v80
    v_mov_b32 v82, v29
    v_mul_f32 v83, v29, v29
    v_add_f32 v52, v52, v53
    v_add_f32 v54, v54, v55
    v_add_f32_dpp v82, v82, v82 quad_perm:[1,0,3,2] row_mask:0xf bank_mask:0xf
    v_add_f32_dpp v83, v83, v83 quad_perm:[1,0,3,2] row_mask:0xf bank_mask:0xf
    v_add_f32 v60, v60, v61
    v_add_f32 v62, v62, v63
    v_add_f32_dpp v82, v82, v82 quad_perm:[2,3,0,1] row_mask:0xf bank_mask:0xf
    v_add_f32_dpp v83, v83, v83 quad_perm:[2,3,0,1] row_mask:0xf bank_mask:0xf
    v_add_f32 v56, v56, v57
    v_add_f32 v58, v58, v59
    v_add_f32_dpp v82, v82, v82 row_half_mirror row_mask:0xf bank_mask:0xf
    v_add_f32_dpp v83, v83, v83 row_half_mirror row_mask:0xf bank_mask:0xf
    v_add_f32 v64, v64, v65
    v_add_f32 v66, v66, v67
    v_add_f32_dpp v82, v82, v82 row_mirror row_mask:0xf bank_mask:0xf
    v_add_f32_dpp v83, v83, v83 row_mirror row_mask:0xf bank_mask:0xf
    v_add_f32 v52, v52, v54
    v_add_f32 v60, v60, v62
    v_add_f32_dpp v82, v82, v82 row_bcast:15 row_mask:0xa bank_mask:0xf
    v_add_f32_dpp v83, v83, v83 row_bcast:15 row_mask:0xa bank_mask:0xf
    v_add_f32 v56, v56, v58
    v_add_f32 v64, v64, v66
    v_add_f32_dpp v82, v82, v82 row_bcast:31 row_mask:0xc bank_mask:0xf
    v_add_f32_dpp v83, v83, v83 row_bcast:31 row_mask:0xc bank_mask:0xf
    v_cndmask_b32 v52, v60, v52, s[100:101]
    v_cndmask_b32 v56, v64, v56, s[100:101]
    s_mov_b32 exec_lo, 0
    s_mov_b32 exec_hi, 0x80000000
    ds_write2_b32 v6, v82, v83 offset0:0 offset1:12
    s_mov_b64 exec, -1
    v_permlane32_swap_b32 v52, v56
    v_add_f32 v52, v52, v56
    v_mov_b32 v56, v52
    s_nop 1
    v_permlane16_swap_b32 v52, v56
    v_add_f32 v52, v52, v56
    v_add_u32 v56, 4294962944, v22
    s_mov_b32 exec_lo, 0xffff
    s_mov_b32 exec_hi, 0xffff
    ds_write_b32 v56, v52
    s_mov_b64 exec, -1
    s_waitcnt lgkmcnt(0)
    s_barrier
    s_cmp_lg_u32 s3, 0
    s_cbranch_scc1 L_lng_done_7
    ds_read_b128 v[44:47], v7
    ds_read_b128 v[48:51], v7 offset:16
    s_cmp_lg_u32 s72, 0
    s_cbranch_scc1 L_nocs_8
    v_add_u32 v60, 4294965760, v7
    ds_read_b128 v[52:55], v60
    ds_read_b128 v[56:59], v60 offset:16
    s_waitcnt lgkmcnt(0)
    v_add_f32 v52, v52, v53
    v_add_f32 v54, v54, v55
    v_add_f32 v56, v56, v57
    v_add_f32 v58, v58, v59
    v_add_f32 v52, v52, v54
    v_add_f32 v56, v56, v58
    v_add_f32 v37, v52, v56
L_nocs_8:
    s_waitcnt lgkmcnt(0)
    v_add_f32 v44, v44, v45
    v_add_f32 v46, v46, v47
    v_add_f32 v48, v48, v49
    v_add_f32 v50, v50, v51
    v_add_f32 v44, v44, v46
    v_add_f32 v48, v48, v50
    v_add_f32 v44, v44, v48
    s_nop 0
    v_readlane_b32 s84, v44, 32
    v_readlane_b32 s85, v44, 33
    s_nop 0
    v_mov_b32 v46, s84
    v_mov_b32 v47, s85
    v_mul_f32 v46, 0x3b000000, v46
    v_mul_f32 v47, 0x3b000000, v47
    v_fma_f32 v47, -v46, v46, v47
    v_fma_f32 v48, -v37, v46, v44
    v_max_f32 v47, 0, v47
    v_add_f32 v47, 0x3727c5ac, v47
    v_rsq_f32 v47, v47
    s_nop 0
    v_mul_f32 v48, v48, v47
    s_nop 1
    v_mov_b32_dpp v49, v48 quad_perm:[1,1,3,3] row_mask:0xf bank_mask:0xf
    v_cvt_pk_bf16_f32 v56, v48, v49
    v_min_u32 v56, -2, v56
    s_mov_b32 exec_lo, 0x55555555
    s_mov_b32 exec_hi, 0
    s_cmp_lg_u32 s72, 0
    s_cbranch_scc1 L_qp1_9
    s_lshl_b32 s84, s95, 11
    s_lshl_b32 s85, s7, 7
    s_add_u32 s84, s84, s85
    s_add_u32 s84, s84, 851968
    v_lshl_add_u32 v58, v1, 2, s84
    s_add_u32 s85, s60, s61
    v_mov_b32 v57, s85
    buffer_store_dwordx2 v[56:57], v58, s[56:59], 0 offen sc1
    s_branch L_qpd_10
L_qp1_9:
    s_cmp_eq_u32 s73, 0
    s_cbranch_scc1 L_pubs_11
    buffer_store_dword v56, v11, s[56:59], 0 offen
    s_branch L_pubd_12
L_pubs_11:
    buffer_store_dword v56, v11, s[56:59], 0 offen sc1
L_pubd_12:
L_qpd_10:
    s_mov_b64 exec, -1
L_lng_done_7:
    s_cmp_lg_u32 s72, 0
    s_cbranch_scc1 L_h1_l1
    v_xor_b32 v106, v2, v3
    v_lshlrev_b32 v106, 4, v106
    v_lshl_add_u32 v106, v3, 8, v106
    s_add_u32 s92, s3, s7
    s_lshl_b32 s93, s3, 13
    s_add_u32 s84, s92, 0
    s_and_b32 s84, s84, 7
    s_and_b32 s85, s84, 3
    s_lshl_b32 s85, s85, 6
    v_xor_b32 v107, s85, v106
    s_lshl_b32 s84, s84, 10
    s_add_u32 s84, s84, s93
    s_add_u32 m0, s84, 65536
    s_nop 0
    buffer_load_dwordx4 v107, s[32:35], s84 offen nt lds
    s_add_u32 s84, s92, 1
    s_and_b32 s84, s84, 7
    s_and_b32 s85, s84, 3
    s_lshl_b32 s85, s85, 6
    v_xor_b32 v107, s85, v106
    s_lshl_b32 s84, s84, 10
    s_add_u32 s84, s84, s93
    s_add_u32 m0, s84, 65536
    s_nop 0
    buffer_load_dwordx4 v107, s[32:35], s84 offen nt lds
    s_add_u32 s84, s92, 2
    s_and_b32 s84, s84, 7
    s_and_b32 s85, s84, 3
    s_lshl_b32 s85, s85, 6
    v_xor_b32 v107, s85, v106
    s_lshl_b32 s84, s84, 10
    s_add_u32 s84, s84, s93
    s_add_u32 m0, s84, 65536
    s_nop 0
    buffer_load_dwordx4 v107, s[32:35], s84 offen nt lds
    s_add_u32 s84, s92, 3
    s_and_b32 s84, s84, 7
    s_and_b32 s85, s84, 3
    s_lshl_b32 s85, s85, 6
    v_xor_b32 v107, s85, v106
    s_lshl_b32 s84, s84, 10
    s_add_u32 s84, s84, s93
    s_add_u32 m0, s84, 65536
    s_nop 0
    buffer_load_dwordx4 v107, s[32:35], s84 offen nt lds
    s_add_u32 s84, s92, 4
    s_and_b32 s84, s84, 7
    s_and_b32 s85, s84, 3
    s_lshl_b32 s85, s85, 6
    v_xor_b32 v107, s85, v106
    s_lshl_b32 s84, s84, 10
    s_add_u32 s84, s84, s93
    s_add_u32 m0, s84, 65536
    s_nop 0
    buffer_load_dwordx4 v107, s[32:35], s84 offen nt lds
    s_add_u32 s84, s92, 5
    s_and_b32 s84, s84, 7
    s_and_b32 s85, s84, 3
    s_lshl_b32 s85, s85, 6
    v_xor_b32 v107, s85, v106
    s_lshl_b32 s84, s84, 10
    s_add_u32 s84, s84, s93
    s_add_u32 m0, s84, 65536
    s_nop 0
    buffer_load_dwordx4 v107, s[32:35], s84 offen nt lds
    s_add_u32 s84, s92, 6
    s_and_b32 s84, s84, 7
    s_and_b32 s85, s84, 3
    s_lshl_b32 s85, s85, 6
    v_xor_b32 v107, s85, v106
    s_lshl_b32 s84, s84, 10
    s_add_u32 s84, s84, s93
    s_add_u32 m0, s84, 65536
    s_nop 0
    buffer_load_dwordx4 v107, s[32:35], s84 offen nt lds
    s_add_u32 s84, s92, 7
    s_and_b32 s84, s84, 7
    s_and_b32 s85, s84, 3
    s_lshl_b32 s85, s85, 6
    v_xor_b32 v107, s85, v106
    s_lshl_b32 s84, s84, 10
    s_add_u32 s84, s84, s93
    s_add_u32 m0, s84, 65536
    s_nop 0
    buffer_load_dwordx4 v107, s[32:35], s84 offen nt lds
    s_barrier
    s_cmp_lg_u32 s3, 1
    s_cbranch_scc1 L_pf3_13
    s_mov_b32 s68, s16
    s_mov_b32 s69, s17
    s_mov_b32 s70, 4194304
    s_mov_b32 s71, 0x20000
    v_and_b32 v104, 15, v1
    s_lshl_b32 s84, s5, 4
    v_add_u32 v104, s84, v104
    v_lshlrev_b32 v104, 10, v104
    s_lshl_b32 s84, s4, 19
    s_add_u32 s84, s84, 384
    v_lshrrev_b32 v105, 4, v1
    v_and_b32 v105, 1, v105
    v_lshl_add_u32 v104, v105, 6, v104
    s_mov_b32 exec_hi, 0
    buffer_load_dword v85, v104, s[68:71], s84 offen
    s_mov_b32 exec_hi, -1
L_pf3_13:
    s_cmp_eq_u32 s3, 0
    s_cbranch_scc1 L_h1_w0
    s_cmp_eq_u32 s3, 7
    s_cbranch_scc1 L_h1_w7
    s_add_u32 s92, s3, s7
    s_and_b32 s92, s92, 3
    s_lshl_b32 s92, s92, 1
    s_lshl_b32 s93, s3, 13
    s_add_u32 s84, s92, 5
    s_and_b32 s84, s84, 7
    s_lshl_b32 s84, s84, 10
    s_add_u32 s84, s84, s93
    s_add_u32 m0, s84, 0
    s_nop 0
    buffer_load_dwordx4 v36, s[36:39], s84 offen nt lds
    s_add_u32 s84, s92, 6
    s_and_b32 s84, s84, 7
    s_lshl_b32 s84, s84, 10
    s_add_u32 s84, s84, s93
    s_add_u32 m0, s84, 0
    s_nop 0
    buffer_load_dwordx4 v35, s[36:39], s84 offen nt lds
    s_add_u32 s84, s92, 7
    s_and_b32 s84, s84, 7
    s_lshl_b32 s84, s84, 10
    s_add_u32 s84, s84, s93
    s_add_u32 m0, s84, 0
    s_nop 0
    buffer_load_dwordx4 v36, s[36:39], s84 offen nt lds
    s_cmp_lg_u32 s3, 1
    s_cbranch_scc1 L_vh1
    s_add_u32 s92, s7, 0
    s_and_b32 s92, s92, 3
    s_lshl_b32 s92, s92, 1
    s_mov_b32 s93, 0
    s_add_u32 s84, s92, 5
    s_and_b32 s84, s84, 7
    s_lshl_b32 s84, s84, 10
    s_add_u32 s84, s84, s93
    s_add_u32 m0, s84, 0
    s_nop 0
    buffer_load_dwordx4 v36, s[36:39], s84 offen nt lds
    s_add_u32 s84, s92, 6
    s_and_b32 s84, s84, 7
    s_lshl_b32 s84, s84, 10
    s_add_u32 s84, s84, s93
    s_add_u32 m0, s84, 0
    s_nop 0
    buffer_load_dwordx4 v35, s[36:39], s84 offen nt lds
    s_add_u32 s84, s92, 7
    s_and_b32 s84, s84, 7
    s_lshl_b32 s84, s84, 10
    s_add_u32 s84, s84, s93
    s_add_u32 m0, s84, 0
    s_nop 0
    buffer_load_dwordx4 v36, s[36:39], s84 offen nt lds
    s_waitcnt vmcnt(6)
    s_branch L_vh_k
L_vh1:
    s_cmp_lg_u32 s3, 6
    s_cbranch_scc1 L_vh2
    s_add_u32 s92, s7, 7
    s_and_b32 s92, s92, 3
    s_lshl_b32 s92, s92, 1
    s_mov_b32 s93, 57344
    s_add_u32 s84, s92, 5
    s_and_b32 s84, s84, 7
    s_lshl_b32 s84, s84, 10
    s_add_u32 s84, s84, s93
    s_add_u32 m0, s84, 0
    s_nop 0
    buffer_load_dwordx4 v36, s[36:39], s84 offen nt lds
    s_add_u32 s84, s92, 6
    s_and_b32 s84, s84, 7
    s_lshl_b32 s84, s84, 10
    s_add_u32 s84, s84, s93
    s_add_u32 m0, s84, 0
    s_nop 0
    buffer_load_dwordx4 v35, s[36:39], s84 offen nt lds
    s_add_u32 s84, s92, 7
    s_and_b32 s84, s84, 7
    s_lshl_b32 s84, s84, 10
    s_add_u32 s84, s84, s93
    s_add_u32 m0, s84, 0
    s_nop 0
    buffer_load_dwordx4 v36, s[36:39], s84 offen nt lds
    s_waitcnt vmcnt(6)
    s_branch L_vh_k
L_vh2:
    s_waitcnt vmcnt(3)
L_vh_k:
    v_xor_b32 v106, v2, v3
    v_lshlrev_b32 v106, 4, v106
    v_lshl_add_u32 v106, v2, 8, v106
    s_lshl_b32 s84, s3, 13
    s_add_u32 s84, s84, 65536
    v_add_u32 v106, s84, v106
    ds_read_b128 v[128:131], v106 offset:0
    ds_read_b128 v[144:147], v106 offset:4096
    v_xor_b32 v107, 64, v106
    ds_read_b128 v[132:135], v107 offset:0
    ds_read_b128 v[148:151], v107 offset:4096
    v_xor_b32 v107, 128, v106
    ds_read_b128 v[136:139], v107 offset:0
    ds_read_b128 v[152:155], v107 offset:4096
    v_xor_b32 v107, 192, v106
    ds_read_b128 v[140:143], v107 offset:0
    ds_read_b128 v[156:159], v107 offset:4096
    s_branch L_h1_bar
L_h1_w7:
    s_lshl_b32 s84, s6, 10
    s_add_u32 s84, s84, 917504
    v_lshrrev_b32 v72, 3, v1
    v_lshlrev_b32 v72, 7, v72
    v_and_b32 v73, 7, v1
    v_lshl_add_u32 v72, v73, 3, v72
    v_add_u32 v72, s84, v72
L_f1_retry:
    buffer_load_dwordx2 v[74:75], v72, s[56:59], 0 offen sc1
    s_waitcnt vmcnt(0)
    v_subrev_u32 v74, s60, v74
    v_subrev_u32 v75, s60, v75
    v_max_u32 v74, v74, v75
    v_cmp_lt_u32 vcc, 15, v74
    s_cbranch_vccz L_h1_rest
    s_add_u32 s81, s81, 1
    s_cmp_lt_u32 s81, 1048576
    s_cbranch_scc1 L_f1_retry
    s_branch L_bail
L_h1_w0:
    s_lshl_b32 s84, s95, 11
    s_add_u32 s84, s84, 851968
    v_lshl_add_u32 v60, v1, 5, s84
L_q0_retry:
    buffer_load_dwordx4 v[44:47], v60, s[56:59], 0 offen sc1
    buffer_load_dwordx4 v[48:51], v60, s[56:59], 0 offen offset:16 sc1
    s_waitcnt vmcnt(0)
    v_subrev_u32 v45, s60, v45
    v_subrev_u32 v47, s60, v47
    v_subrev_u32 v49, s60, v49
    v_subrev_u32 v51, s60, v51
    v_max3_u32 v52, v45, v47, v49
    v_max_u32 v52, v52, v51
    v_cmp_lt_u32 vcc, 15, v52
    s_cbranch_vccz L_q0_ok
    s_add_u32 s81, s81, 1
    s_cmp_lt_u32 s81, 1048576
    s_cbranch_scc1 L_q0_retry
    s_branch L_bail
L_q0_ok:
    v_min3_u32 v53, v45, v47, v49
    v_min_u32 v53, v53, v51
    v_cmp_ne_u32 vcc, s61, v52
    v_cmp_ne_u32 s[92:93], s61, v53
    s_nop 0
    s_or_b64 vcc, vcc, s[92:93]
    s_cmp_eq_u64 vcc, 0
    s_cselect_b32 s84, 1, 0
    v_mul_u32_u24 v54, 320, v3
    v_lshl_add_u32 v54, v2, 4, v54
    v_add_u32 v54, 141952, v54
    ds_write2_b32 v54, v44, v46 offset0:0 offset1:1
    ds_write2_b32 v54, v48, v50 offset0:2 offset1:3
    v_mov_b32 v55, s84
    v_mov_b32 v56, 141824
    ds_write_b32 v56, v55
L_h1_rest:
    v_xor_b32 v106, v2, v3
    v_lshlrev_b32 v106, 4, v106
    v_lshl_add_u32 v106, v2, 8, v106
    s_lshl_b32 s84, s3, 13
    s_add_u32 s84, s84, 65536
    v_add_u32 v106, s84, v106
    ds_read_b128 v[128:131], v106 offset:0
    ds_read_b128 v[144:147], v106 offset:4096
    v_xor_b32 v107, 64, v106
    ds_read_b128 v[132:135], v107 offset:0
    ds_read_b128 v[148:151], v107 offset:4096
    v_xor_b32 v107, 128, v106
    ds_read_b128 v[136:139], v107 offset:0
    ds_read_b128 v[152:155], v107 offset:4096
    v_xor_b32 v107, 192, v106
    ds_read_b128 v[140:143], v107 offset:0
    ds_read_b128 v[156:159], v107 offset:4096
    s_branch L_h1_bar
L_h1_l1:
    s_cmp_lg_u32 s3, 0
    s_cbranch_scc1 L_h1_bar
    s_waitcnt vmcnt(0)
L_q1_retry:
    buffer_load_dwordx4 v[44:47], v10, s[56:59], 0 offen sc1
    s_waitcnt vmcnt(0)
    v_max3_u32 v48, v44, v45, v46
    v_max_u32 v48, v48, v47
    v_cmp_eq_u32 vcc, -1, v48
    s_cbranch_vccz L_q1_ok
    s_add_u32 s81, s81, 1
    s_cmp_lt_u32 s81, 1048576
    s_cbranch_scc1 L_q1_retry
    s_branch L_bail
L_q1_ok:
    v_mul_u32_u24 v54, 320, v3
    v_lshl_add_u32 v54, v2, 4, v54
    v_add_u32 v54, 141952, v54
    ds_write_b128 v54, v[44:47]
L_h1_bar:
    s_waitcnt lgkmcnt(0)
    s_barrier
    s_cmp_lg_u32 s72, 0
    s_cbranch_scc1 L_nopt
    s_cmp_lg_u32 s3, 6
    s_cbranch_scc1 L_nopt
    s_mul_i32 s84, s95, 49152
    s_lshl_b32 s85, s7, 10
    s_add_u32 s85, s85, 8192
    v_and_b32 v114, 7, v1
    v_lshlrev_b32 v114, 7, v114
    v_lshrrev_b32 v115, 3, v1
    v_and_b32 v115, 1, v115
    v_lshl_add_u32 v114, v115, 14, v114
    v_add_u32 v114, s85, v114
    v_subrev_u32 v115, 16, v1
    s_lshl_b32 s85, s7, 2
    v_add_u32 v115, s85, v115
    v_min_u32 v115, 39, v115
    v_lshlrev_b32 v115, 7, v115
    v_cmp_gt_u32 vcc, 16, v1
    s_nop 1
    v_cndmask_b32 v114, v115, v114, vcc
    s_mov_b32 exec_lo, 0xfffff
    s_mov_b32 exec_hi, 0
    buffer_load_dword v127, v114, s[56:59], s84 offen sc1
    s_mov_b64 exec, -1
L_nopt:
    ds_read_b128 v[44:47], v43 offset:0
    ds_read_b128 v[48:51], v43 offset:64
    ds_read_b128 v[52:55], v43 offset:128
    ds_read_b128 v[56:59], v43 offset:192
    v_mov_b32 v70, 141824
    ds_read_b32 v71, v70
    s_waitcnt lgkmcnt(4)
    v_mfma_f32_16x16x32_bf16 v[60:63], v[128:131], v[44:47], 0
    v_mfma_f32_16x16x32_bf16 v[64:67], v[144:147], v[44:47], 0
    s_waitcnt lgkmcnt(3)
    v_mfma_f32_16x16x32_bf16 v[60:63], v[132:135], v[48:51], v[60:63]
    v_mfma_f32_16x16x32_bf16 v[64:67], v[148:151], v[48:51], v[64:67]
    s_waitcnt lgkmcnt(2)
    v_mfma_f32_16x16x32_bf16 v[60:63], v[136:139], v[52:55], v[60:63]
    v_mfma_f32_16x16x32_bf16 v[64:67], v[152:155], v[52:55], v[64:67]
    s_waitcnt lgkmcnt(1)
    v_mfma_f32_16x16x32_bf16 v[60:63], v[140:143], v[56:59], v[60:63]
    v_mfma_f32_16x16x32_bf16 v[64:67], v[156:159], v[56:59], v[64:67]
    s_cmp_lg_u32 s72, 0
    s_cbranch_scc1 L_wos
    s_lshl_b32 s84, s3, 13
    s_add_u32 m0, s84, 69632
    s_nop 0
    buffer_load_dwordx4 v38, s[44:47], 0 offen offset:0 nt lds
    s_mov_b32 s85, 15360
    buffer_load_dwordx4 v38, s[44:47], s85 offen offset:1024 nt lds
    s_mov_b32 s85, 30720
    buffer_load_dwordx4 v38, s[44:47], s85 offen offset:2048 nt lds
    s_mov_b32 s85, 46080
    buffer_load_dwordx4 v38, s[44:47], s85 offen offset:3072 nt lds
L_wos:
    s_waitcnt lgkmcnt(0)
    v_readfirstlane_b32 s73, v71
    s_nop 2
    v_max3_f32 v68, v60, v61, v62
    v_max3_f32 v69, v64, v65, v66
    v_max3_f32 v68, v68, v63, v67
    v_max_f32 v68, v68, v69
    v_mov_b32 v70, v68
    s_nop 1
    v_permlane16_swap_b32 v68, v70
    v_max_f32 v68, v68, v70
    v_mov_b32 v70, v68
    s_nop 1
    v_permlane32_swap_b32 v68, v70
    v_max_f32 v68, v68, v70
    v_mul_f32 v72, s83, v68
    v_fma_f32 v76, v60, s83, -v72
    v_fma_f32 v77, v61, s83, -v72
    v_fma_f32 v78, v62, s83, -v72
    v_fma_f32 v79, v63, s83, -v72
    v_fma_f32 v80, v64, s83, -v72
    v_fma_f32 v81, v65, s83, -v72
    v_fma_f32 v82, v66, s83, -v72
    v_fma_f32 v83, v67, s83, -v72
    v_exp_f32 v76, v76
    v_exp_f32 v77, v77
    v_exp_f32 v78, v78
    v_exp_f32 v79, v79
    v_exp_f32 v80, v80
    v_exp_f32 v81, v81
    v_exp_f32 v82, v82
    v_exp_f32 v83, v83
    v_cvt_pk_bf16_f32 v84, v76, v77
    v_cvt_pk_bf16_f32 v85, v78, v79
    v_cvt_pk_bf16_f32 v86, v80, v81
    v_cvt_pk_bf16_f32 v87, v82, v83
    s_mov_b64 exec, s[86:87]
    ds_write_b128 v18, v[84:87]
    s_mov_b64 exec, -1
    v_add_f32 v76, v76, v77
    v_add_f32 v78, v78, v79
    v_add_f32 v80, v80, v81
    v_add_f32 v82, v82, v83
    v_add_f32 v76, v76, v78
    v_add_f32 v80, v80, v82
    v_add_f32 v73, v76, v80
    v_mov_b32 v70, v73
    s_nop 1
    v_permlane16_swap_b32 v73, v70
    v_add_f32 v73, v73, v70
    v_mov_b32 v70, v73
    s_nop 1
    v_permlane32_swap_b32 v73, v70
    v_add_f32 v73, v73, v70
    s_mov_b64 exec, 15
    ds_write_b64 v20, v[72:73]
    s_mov_b64 exec, -1
    s_cmp_lg_u32 s72, 0
    s_cbranch_scc1 L_p2_nov
    s_waitcnt vmcnt(4)
L_p2_nov:
    s_waitcnt lgkmcnt(0)
    s_barrier
    s_cmp_lg_u32 s72, 0
    s_cbranch_scc1 L_p2_novt
    ds_read_b64_tr_b16 v[160:161], v33 offset:0
    ds_read_b64_tr_b16 v[162:163], v33 offset:4096
    ds_read_b64_tr_b16 v[164:165], v33 offset:8192
    ds_read_b64_tr_b16 v[166:167], v33 offset:12288
    ds_read_b64_tr_b16 v[168:169], v33 offset:16384
    ds_read_b64_tr_b16 v[170:171], v33 offset:20480
    ds_read_b64_tr_b16 v[172:173], v33 offset:24576
    ds_read_b64_tr_b16 v[174:175], v33 offset:28672
    ds_read_b64_tr_b16 v[176:177], v33 offset:32768
    ds_read_b64_tr_b16 v[178:179], v33 offset:36864
    ds_read_b64_tr_b16 v[180:181], v33 offset:40960
    ds_read_b64_tr_b16 v[182:183], v33 offset:45056
    ds_read_b64_tr_b16 v[184:185], v33 offset:49152
    ds_read_b64_tr_b16 v[186:187], v33 offset:53248
    ds_read_b64_tr_b16 v[188:189], v33 offset:57344
    ds_read_b64_tr_b16 v[190:191], v33 offset:61440
    s_waitcnt lgkmcnt(0)
    s_barrier
L_p2_novt:
    ds_read_b64 v[76:77], v21
    ds_read_b128 v[44:47], v19 offset:0
    ds_read_b128 v[48:51], v19 offset:256
    ds_read_b128 v[52:55], v19 offset:512
    ds_read_b128 v[56:59], v19 offset:768
    ds_read_b128 v[60:63], v19 offset:1024
    ds_read_b128 v[64:67], v19 offset:1280
    ds_read_b128 v[68:71], v19 offset:1536
    ds_read_b128 v[72:75], v19 offset:1792
    s_waitcnt lgkmcnt(7)
    v_mfma_f32_16x16x32_bf16 v[92:95], v[44:47], v[160:163], 0
    v_max_f32_dpp v124, v76, v76 quad_perm:[1,0,3,2] row_mask:0xf bank_mask:0xf
    s_waitcnt lgkmcnt(6)
    v_mfma_f32_16x16x32_bf16 v[96:99], v[48:51], v[164:167], 0
    v_max_f32_dpp v124, v124, v124 quad_perm:[2,3,0,1] row_mask:0xf bank_mask:0xf
    s_waitcnt lgkmcnt(5)
    v_mfma_f32_16x16x32_bf16 v[100:103], v[52:55], v[168:171], 0
    v_max_f32_dpp v124, v124, v124 row_half_mirror row_mask:0xf bank_mask:0xf
    v_sub_f32 v76, v76, v124
    v_exp_f32 v76, v76
    s_waitcnt lgkmcnt(4)
    v_mfma_f32_16x16x32_bf16 v[104:107], v[56:59], v[172:175], 0
    v_mul_f32 v125, v76, v77
    s_waitcnt lgkmcnt(3)
    v_mfma_f32_16x16x32_bf16 v[108:111], v[60:63], v[176:179], 0
    v_add_f32_dpp v125, v125, v125 quad_perm:[1,0,3,2] row_mask:0xf bank_mask:0xf
    s_waitcnt lgkmcnt(2)
    v_mfma_f32_16x16x32_bf16 v[112:115], v[64:67], v[180:183], 0
    v_add_f32_dpp v125, v125, v125 quad_perm:[2,3,0,1] row_mask:0xf bank_mask:0xf
    v_mul_f32_dpp v126, v76, v92 row_newbcast:0 row_mask:0xf bank_mask:0xf
    v_mul_f32_dpp v127, v76, v96 row_newbcast:1 row_mask:0xf bank_mask:0xf
    s_waitcnt lgkmcnt(1)
    v_mfma_f32_16x16x32_bf16 v[116:119], v[68:71], v[184:187], 0
    v_add_f32_dpp v125, v125, v125 row_half_mirror row_mask:0xf bank_mask:0xf
    v_fmac_f32_dpp v126, v76, v100 row_newbcast:2 row_mask:0xf bank_mask:0xf
    v_fmac_f32_dpp v127, v76, v104 row_newbcast:3 row_mask:0xf bank_mask:0xf
    s_waitcnt lgkmcnt(0)
    v_mfma_f32_16x16x32_bf16 v[120:123], v[72:75], v[188:191], 0
    v_fmac_f32_dpp v126, v76, v108 row_newbcast:4 row_mask:0xf bank_mask:0xf
    v_fmac_f32_dpp v127, v76, v112 row_newbcast:5 row_mask:0xf bank_mask:0xf
    s_nop 0
    v_fmac_f32_dpp v126, v76, v116 row_newbcast:6 row_mask:0xf bank_mask:0xf
    s_nop 3
    v_fmac_f32_dpp v127, v76, v120 row_newbcast:7 row_mask:0xf bank_mask:0xf
    v_add_f32 v126, v126, v127
    s_nop 1
    v_mov_b32_dpp v127, v126 quad_perm:[1,1,3,3] row_mask:0xf bank_mask:0xf
    v_cvt_pk_bf16_f32 v126, v126, v127
    v_min_u32 v126, -2, v126
    s_mov_b64 exec, s[88:89]
    s_cmp_eq_u32 s73, 0
    s_cbranch_scc1 L_pubs_14
    buffer_store_dword v126, v14, s[56:59], s80 offen
    s_branch L_pubd_15
L_pubs_14:
    buffer_store_dword v126, v14, s[56:59], s80 offen sc1
L_pubd_15:
    s_cmp_lg_u32 s3, 0
    s_cbranch_scc1 L_p2_noml
    v_min_u32 v124, -2, v124
    v_min_u32 v125, -2, v125
    s_mov_b64 exec, s[90:91]
    s_cmp_eq_u32 s73, 0
    s_cbranch_scc1 L_pubs_16
    buffer_store_dwordx2 v[124:125], v16, s[56:59], s77 offen
    s_branch L_pubd_17
L_pubs_16:
    buffer_store_dwordx2 v[124:125], v16, s[56:59], s77 offen sc1
L_pubd_17:
L_p2_noml:
    s_mov_b64 exec, -1
    s_waitcnt vmcnt(0)
    s_lshl_b32 s84, s3, 11
    s_add_u32 m0, s84, 0
    s_nop 0
    buffer_load_dwordx4 v15, s[56:59], s80 offen sc1 lds
    buffer_load_dwordx4 v15, s[56:59], s62 offen offset:1024 sc1 lds
    buffer_load_dwordx4 v[52:55], v17, s[56:59], s77 offen sc1
    buffer_load_dwordx4 v[56:59], v17, s[56:59], s77 offen offset:16 sc1
    s_cmp_lg_u32 s72, 0
    s_cbranch_scc1 L_o_wait
    ds_read_b64_tr_b16 v[208:209], v31 offset:4096
    ds_read_b64_tr_b16 v[210:211], v31 offset:4352
    ds_read_b64_tr_b16 v[212:213], v32 offset:4096
    ds_read_b64_tr_b16 v[214:215], v32 offset:4352
    ds_read_b64_tr_b16 v[216:217], v31 offset:6144
    ds_read_b64_tr_b16 v[218:219], v31 offset:6400
    ds_read_b64_tr_b16 v[220:221], v32 offset:6144
    ds_read_b64_tr_b16 v[222:223], v32 offset:6400
    s_branch L_o_wait
L_o_retry:
    s_lshl_b32 s84, s3, 11
    s_add_u32 m0, s84, 0
    s_nop 0
    buffer_load_dwordx4 v15, s[56:59], s80 offen sc1 lds
    buffer_load_dwordx4 v15, s[56:59], s62 offen offset:1024 sc1 lds
    buffer_load_dwordx4 v[52:55], v17, s[56:59], s77 offen sc1
    buffer_load_dwordx4 v[56:59], v17, s[56:59], s77 offen offset:16 sc1
L_o_wait:
    s_waitcnt vmcnt(0)
L_o_chk:
    ds_read_b128 v[44:47], v41
    ds_read_b128 v[48:51], v42
    s_waitcnt lgkmcnt(0)
    v_max3_u32 v60, v44, v45, v46
    v_max3_u32 v61, v47, v48, v49
    v_max3_u32 v60, v60, v50, v51
    v_max3_u32 v61, v61, v52, v53
    v_max3_u32 v60, v60, v54, v55
    v_max3_u32 v61, v61, v56, v57
    v_max3_u32 v60, v60, v58, v59
    v_max_u32 v60, v60, v61
    v_cmp_eq_u32 vcc, -1, v60
    s_cbranch_vccz L_o_ok
    s_add_u32 s81, s81, 1
    s_cmp_lt_u32 s81, 1048576
    s_cbranch_scc1 L_o_retry
    s_branch L_bail
L_o_ok:
    s_cmp_lg_u32 s72, 0
    s_cbranch_scc1 L_p3_go
    s_cmp_ge_u32 s7, 14
    s_cbranch_scc1 L_p3_go
    s_lshl_b32 s84, s3, 13
    s_add_u32 m0, s84, 65536
    s_nop 0
    buffer_load_dwordx4 v39, s[48:51], 0 offen offset:0 nt lds
    s_mov_b32 s85, 56320
    buffer_load_dwordx4 v39, s[48:51], s85 offen offset:1024 nt lds
    s_mov_b32 s85, 112640
    buffer_load_dwordx4 v39, s[48:51], s85 offen offset:2048 nt lds
    s_mov_b32 s85, 168960
    buffer_load_dwordx4 v39, s[48:51], s85 offen offset:3072 nt lds
L_p3_go:
    v_mfma_f32_16x16x32_bf16 v[60:63], v[44:47], v[208:211], 0
    v_mfma_f32_16x16x32_bf16 v[64:67], v[44:47], v[212:215], 0
    v_mfma_f32_16x16x32_bf16 v[60:63], v[48:51], v[216:219], v[60:63]
    v_mfma_f32_16x16x32_bf16 v[64:67], v[48:51], v[220:223], v[64:67]
    v_max3_f32 v68, v52, v54, v56
    v_max_f32 v68, v68, v58
    v_mov_b32 v69, v68
    s_nop 1
    v_permlane16_swap_b32 v68, v69
    v_max_f32 v68, v68, v69
    v_mov_b32 v69, v68
    s_nop 1
    v_permlane32_swap_b32 v68, v69
    v_max_f32 v68, v68, v69
    v_sub_f32 v52, v52, v68
    v_sub_f32 v54, v54, v68
    v_sub_f32 v56, v56, v68
    v_sub_f32 v58, v58, v68
    v_exp_f32 v52, v52
    v_exp_f32 v54, v54
    v_exp_f32 v56, v56
    v_exp_f32 v58, v58
    v_mul_f32 v70, v52, v53
    v_fmac_f32 v70, v54, v55
    v_fmac_f32 v70, v56, v57
    v_fmac_f32 v70, v58, v59
    v_mov_b32 v69, v70
    v_mul_f32 v71, v52, v60
    v_mul_f32 v72, v52, v64
    v_permlane16_swap_b32 v70, v69
    v_add_f32 v70, v70, v69
    v_fmac_f32 v71, v54, v61
    v_fmac_f32 v72, v54, v65
    v_mov_b32 v69, v70
    v_fmac_f32 v71, v56, v62
    v_fmac_f32 v72, v56, v66
    v_permlane32_swap_b32 v70, v69
    v_add_f32 v70, v70, v69
    v_fmac_f32 v71, v58, v63
    v_fmac_f32 v72, v58, v67
    v_rcp_f32 v70, v70
    s_nop 0
    v_permlane32_swap_b32 v71, v72
    v_add_f32 v71, v71, v72
    v_mov_b32 v69, v71
    s_nop 1
    v_permlane16_swap_b32 v71, v69
    v_add_f32 v71, v71, v69
    v_mul_f32 v71, v71, v70
    s_mov_b32 exec_lo, 0xffff
    s_mov_b32 exec_hi, 0xffff
    ds_write_b32 v22, v71
    s_mov_b64 exec, -1
    s_waitcnt lgkmcnt(0)
    s_barrier
    s_cmp_eq_u32 s3, 0
    s_cbranch_scc1 L_f8x_18
    s_cmp_lg_u32 s72, 0
    s_cbranch_scc1 L_ptr_19
    s_cmp_ge_u32 s7, 14
    s_cbranch_scc1 L_ptr_19
    s_waitcnt vmcnt(0)
    ds_read_b64_tr_b16 v[224:225], v31 offset:0
    ds_read_b64_tr_b16 v[226:227], v31 offset:256
    ds_read_b64_tr_b16 v[228:229], v32 offset:0
    ds_read_b64_tr_b16 v[230:231], v32 offset:256
    ds_read_b64_tr_b16 v[232:233], v31 offset:2048
    ds_read_b64_tr_b16 v[234:235], v31 offset:2304
    ds_read_b64_tr_b16 v[236:237], v32 offset:2048
    ds_read_b64_tr_b16 v[238:239], v32 offset:2304
    s_waitcnt lgkmcnt(0)
L_ptr_19:
    s_branch L_p3_done
L_f8x_18:
    ds_read_b128 v[44:47], v23
    ds_read_b128 v[48:51], v23 offset:16
    s_waitcnt lgkmcnt(0)
    v_add_f32 v44, v44, v45
    v_add_f32 v46, v46, v47
    v_add_f32 v48, v48, v49
    v_add_f32 v50, v50, v51
    v_add_f32 v44, v44, v46
    v_add_f32 v48, v48, v50
    v_add_f32 v44, v44, v48
    s_nop 1
    v_mov_b32_dpp v45, v44 quad_perm:[1,1,3,3] row_mask:0xf bank_mask:0xf
    v_cvt_pk_bf16_f32 v44, v44, v45
    v_min_u32 v44, -2, v44
    s_mov_b32 exec_lo, 0x55555555
    s_mov_b32 exec_hi, 0
    buffer_store_dword v44, v9, s[56:59], s78 offen sc1
    s_mov_b64 exec, -1
    s_cmp_lg_u32 s72, 0
    s_cbranch_scc1 L_ptr_20
    s_cmp_ge_u32 s7, 14
    s_cbranch_scc1 L_ptr_20
    s_waitcnt vmcnt(0)
    ds_read_b64_tr_b16 v[224:225], v31 offset:0
    ds_read_b64_tr_b16 v[226:227], v31 offset:256
    ds_read_b64_tr_b16 v[228:229], v32 offset:0
    ds_read_b64_tr_b16 v[230:231], v32 offset:256
    ds_read_b64_tr_b16 v[232:233], v31 offset:2048
    ds_read_b64_tr_b16 v[234:235], v31 offset:2304
    ds_read_b64_tr_b16 v[236:237], v32 offset:2048
    ds_read_b64_tr_b16 v[238:239], v32 offset:2304
    s_waitcnt lgkmcnt(0)
L_ptr_20:
    s_waitcnt vmcnt(0)
L_p3_done:
    s_barrier
    s_branch L_p4_w
L_p4_idle:
    s_branch L_p4_idle9
L_p4_w:
    s_cmp_ge_u32 s7, 14
    s_cbranch_scc1 L_p4_idle1
    ds_read_b128 v[44:47], v5
    ds_read_b128 v[48:51], v5 offset:64
    s_waitcnt lgkmcnt(0)
    v_mfma_f32_16x16x32_bf16 v[52:55], v[44:47], v[224:227], 0
    v_mfma_f32_16x16x32_bf16 v[56:59], v[44:47], v[228:231], 0
    v_mfma_f32_16x16x32_bf16 v[52:55], v[48:51], v[232:235], v[52:55]
    v_mfma_f32_16x16x32_bf16 v[56:59], v[48:51], v[236:239], v[56:59]
    s_cmp_lg_u32 s72, 0
    s_cbranch_scc1 L_cs_21
    v_mov_b32 v84, 0x3f803f80
    v_mov_b32 v85, 0x3f803f80
    v_mov_b32 v86, 0x3f803f80
    v_mov_b32 v87, 0x3f803f80
    s_nop 1
    v_mfma_f32_16x16x32_bf16 v[88:91], v[84:87], v[224:227], 0
    v_mfma_f32_16x16x32_bf16 v[92:95], v[84:87], v[228:231], 0
    v_mfma_f32_16x16x32_bf16 v[88:91], v[84:87], v[232:235], v[88:91]
    v_mfma_f32_16x16x32_bf16 v[92:95], v[84:87], v[236:239], v[92:95]
    s_nop 7
    v_cndmask_b32 v88, v92, v88, s[100:101]
    s_mov_b32 exec_lo, 0xffff
    s_mov_b32 exec_hi, 0xffff
    v_add_u32 v89, 4294961408, v22
    ds_write_b32 v89, v88
    s_mov_b64 exec, -1
L_cs_21:
    buffer_load_dwordx4 v[68:71], v8, s[56:59], s78 offen sc1
    s_waitcnt vmcnt(0)
L_pd_c_24:
    v_max3_u32 v84, v68, v69, v70
    v_max_u32 v84, v84, v71
    v_cmp_eq_u32 vcc, -1, v84
    s_cbranch_vccz L_pd_ok_23
    s_add_u32 s81, s81, 1
    s_cmp_lt_u32 s81, 1048576
    s_cbranch_scc1 L_pd_r_22
    s_branch L_bail
L_pd_r_22:
    buffer_load_dwordx4 v[68:71], v8, s[56:59], s78 offen sc1
    s_waitcnt vmcnt(0)
    s_branch L_pd_c_24
L_pd_ok_23:
    s_cmp_lg_u32 s72, 0
    s_cbranch_scc1 L_p4_nowd
    s_cmp_eq_u32 s3, 7
    s_cbranch_scc1 L_p4_nowd
    s_lshl_b32 s84, s3, 13
    s_add_u32 m0, s84, 69632
    s_nop 0
    buffer_load_dwordx4 v40, s[52:55], 0 offen offset:0 nt lds
    s_mov_b32 s85, 15360
    buffer_load_dwordx4 v40, s[52:55], s85 offen offset:1024 nt lds
L_p4_nowd:
    v_mfma_f32_16x16x32_bf16 v[72:75], v[68:71], v[248:251], 0
    v_mfma_f32_16x16x32_bf16 v[76:79], v[68:71], v[252:255], 0
    v_mfma_f32_16x16x32_bf16 v[52:55], v[68:71], v[224:227], v[52:55]
    v_mfma_f32_16x16x32_bf16 v[56:59], v[68:71], v[228:231], v[56:59]
    v_mfma_f32_16x16x32_bf16 v[60:63], v[68:71], v[232:235], 0
    v_mfma_f32_16x16x32_bf16 v[64:67], v[68:71], v[236:239], 0
    s_nop 2
    v_add_f32 v72, v72, v73
    v_add_f32 v74, v74, v75
    v_add_f32 v76, v76, v77
    v_add_f32 v78, v78, v79
    v_add_f32 v72, v72, v74
    v_add_f32 v76, v76, v78
    s_nop 1
    v_permlane16_swap_b32 v72, v76
    v_add_f32 v72, v72, v76
    v_cvt_pk_bf16_f32 v72, v72, v72
    v_and_b32 v72, 0xffff0000, v72
    v_add_f32 v29, v29, v72
    v_cvt_pk_bf16_f32 v80, v29, v29
    v_and_b32 v29, 0xffff0000, v80
    ds_write_b16 v4, v80
    v_mov_b32 v82, v29
    v_mul_f32 v83, v29, v29
    v_add_f32 v52, v52, v53
    v_add_f32 v54, v54, v55
    v_add_f32_dpp v82, v82, v82 quad_perm:[1,0,3,2] row_mask:0xf bank_mask:0xf
    v_add_f32_dpp v83, v83, v83 quad_perm:[1,0,3,2] row_mask:0xf bank_mask:0xf
    v_add_f32 v60, v60, v61
    v_add_f32 v62, v62, v63
    v_add_f32_dpp v82, v82, v82 quad_perm:[2,3,0,1] row_mask:0xf bank_mask:0xf
    v_add_f32_dpp v83, v83, v83 quad_perm:[2,3,0,1] row_mask:0xf bank_mask:0xf
    v_add_f32 v56, v56, v57
    v_add_f32 v58, v58, v59
    v_add_f32_dpp v82, v82, v82 row_half_mirror row_mask:0xf bank_mask:0xf
    v_add_f32_dpp v83, v83, v83 row_half_mirror row_mask:0xf bank_mask:0xf
    v_add_f32 v64, v64, v65
    v_add_f32 v66, v66, v67
    v_add_f32_dpp v82, v82, v82 row_mirror row_mask:0xf bank_mask:0xf
    v_add_f32_dpp v83, v83, v83 row_mirror row_mask:0xf bank_mask:0xf
    v_add_f32 v52, v52, v54
    v_add_f32 v60, v60, v62
    v_add_f32_dpp v82, v82, v82 row_bcast:15 row_mask:0xa bank_mask:0xf
    v_add_f32_dpp v83, v83, v83 row_bcast:15 row_mask:0xa bank_mask:0xf
    v_add_f32 v56, v56, v58
    v_add_f32 v64, v64, v66
    v_add_f32_dpp v82, v82, v82 row_bcast:31 row_mask:0xc bank_mask:0xf
    v_add_f32_dpp v83, v83, v83 row_bcast:31 row_mask:0xc bank_mask:0xf
    v_cndmask_b32 v52, v60, v52, s[100:101]
    v_cndmask_b32 v56, v64, v56, s[100:101]
    s_mov_b32 exec_lo, 0
    s_mov_b32 exec_hi, 0x80000000
    ds_write2_b32 v6, v82, v83 offset0:0 offset1:12
    s_mov_b64 exec, -1
    v_permlane32_swap_b32 v52, v56
    v_add_f32 v52, v52, v56
    v_mov_b32 v56, v52
    s_nop 1
    v_permlane16_swap_b32 v52, v56
    v_add_f32 v52, v52, v56
    v_add_u32 v56, 4294962944, v22
    s_mov_b32 exec_lo, 0xffff
    s_mov_b32 exec_hi, 0xffff
    ds_write_b32 v56, v52
    s_mov_b64 exec, -1
    s_waitcnt lgkmcnt(0)
    s_barrier
    s_cmp_lg_u32 s3, 0
    s_cbranch_scc1 L_lng_done_25
    ds_read_b128 v[44:47], v7
    ds_read_b128 v[48:51], v7 offset:16
    s_cmp_lg_u32 s72, 0
    s_cbranch_scc1 L_nocs_26
    v_add_u32 v60, 4294965760, v7
    ds_read_b128 v[52:55], v60
    ds_read_b128 v[56:59], v60 offset:16
    s_waitcnt lgkmcnt(0)
    v_add_f32 v52, v52, v53
    v_add_f32 v54, v54, v55
    v_add_f32 v56, v56, v57
    v_add_f32 v58, v58, v59
    v_add_f32 v52, v52, v54
    v_add_f32 v56, v56, v58
    v_add_f32 v34, v52, v56
L_nocs_26:
    s_waitcnt lgkmcnt(0)
    v_add_f32 v44, v44, v45
    v_add_f32 v46, v46, v47
    v_add_f32 v48, v48, v49
    v_add_f32 v50, v50, v51
    v_add_f32 v44, v44, v46
    v_add_f32 v48, v48, v50
    v_add_f32 v44, v44, v48
    s_nop 0
    v_readlane_b32 s84, v44, 32
    v_readlane_b32 s85, v44, 33
    s_nop 0
    v_mov_b32 v46, s84
    v_mov_b32 v47, s85
    v_mul_f32 v46, 0x3b000000, v46
    v_mul_f32 v47, 0x3b000000, v47
    v_fma_f32 v47, -v46, v46, v47
    v_fma_f32 v48, -v34, v46, v44
    v_max_f32 v47, 0, v47
    v_add_f32 v47, 0x3727c5ac, v47
    v_rsq_f32 v47, v47
    s_nop 0
    v_mul_f32 v48, v48, v47
    s_nop 1
    v_mov_b32_dpp v49, v48 quad_perm:[1,1,3,3] row_mask:0xf bank_mask:0xf
    v_cvt_pk_bf16_f32 v56, v48, v49
    v_min_u32 v56, -2, v56
    s_mov_b32 exec_lo, 0x55555555
    s_mov_b32 exec_hi, 0
    s_cmp_eq_u32 s73, 0
    s_cbranch_scc1 L_pubs_27
    buffer_store_dword v56, v12, s[56:59], s76 offen
    s_branch L_pubd_28
L_pubs_27:
    buffer_store_dword v56, v12, s[56:59], s76 offen sc1
L_pubd_28:
    s_cmp_eq_u32 s72, 0
    s_cbranch_scc1 L_gua_29
    s_waitcnt vmcnt(0)
L_gua_29:
    s_mov_b64 exec, -1
L_lng_done_25:
    s_barrier
    s_branch L_p4_done
L_p4_idle1:
    buffer_load_dwordx4 v[68:71], v8, s[56:59], s78 offen sc1
L_p4_idle0:
    s_waitcnt vmcnt(0)
L_p4_idle9:
L_pd_c_32:
    v_max3_u32 v84, v68, v69, v70
    v_max_u32 v84, v84, v71
    v_cmp_eq_u32 vcc, -1, v84
    s_cbranch_vccz L_pd_ok_31
    s_add_u32 s81, s81, 1
    s_cmp_lt_u32 s81, 1048576
    s_cbranch_scc1 L_pd_r_30
    s_branch L_bail
L_pd_r_30:
    buffer_load_dwordx4 v[68:71], v8, s[56:59], s78 offen sc1
    s_waitcnt vmcnt(0)
    s_branch L_pd_c_32
L_pd_ok_31:
    s_cmp_lg_u32 s72, 0
    s_cbranch_scc1 L_p4_nowd2
    s_cmp_eq_u32 s3, 7
    s_cbranch_scc1 L_p4_nowd2
    s_lshl_b32 s84, s3, 13
    s_add_u32 m0, s84, 69632
    s_nop 0
    buffer_load_dwordx4 v40, s[52:55], 0 offen offset:0 nt lds
    s_mov_b32 s85, 15360
    buffer_load_dwordx4 v40, s[52:55], s85 offen offset:1024 nt lds
L_p4_nowd2:
    v_mfma_f32_16x16x32_bf16 v[72:75], v[68:71], v[248:251], 0
    v_mfma_f32_16x16x32_bf16 v[76:79], v[68:71], v[252:255], 0
    s_nop 6
    v_add_f32 v72, v72, v73
    v_add_f32 v74, v74, v75
    v_add_f32 v76, v76, v77
    v_add_f32 v78, v78, v79
    v_add_f32 v72, v72, v74
    v_add_f32 v76, v76, v78
    s_nop 1
    v_permlane16_swap_b32 v72, v76
    v_add_f32 v72, v72, v76
    v_cvt_pk_bf16_f32 v72, v72, v72
    v_and_b32 v72, 0xffff0000, v72
    v_add_f32 v29, v29, v72
    v_cvt_pk_bf16_f32 v80, v29, v29
    v_and_b32 v29, 0xffff0000, v80
    ds_write_b16 v4, v80
L_p4_done:
    s_cmp_eq_u32 s3, 7
    s_cbranch_scc1 L_p5_bar
L_gu_retry:
    buffer_load_dword v44, v13, s[56:59], s76 offen sc1
    buffer_load_dword v45, v13, s[56:59], s76 offen offset:512 sc1
L_gu_wait:
    s_waitcnt vmcnt(0)
    v_max_u32 v46, v44, v45
    v_cmp_eq_u32 vcc, -1, v46
    s_cbranch_vccz L_gu_ok
    s_add_u32 s81, s81, 1
    s_cmp_lt_u32 s81, 1048576
    s_cbranch_scc1 L_gu_retry
    s_branch L_bail
L_gu_ok:
    s_cmp_lg_u32 s72, 0
    s_cbranch_scc1 L_gu_nowd
    ds_read_b64_tr_b16 v[240:241], v31 offset:4096
    ds_read_b64_tr_b16 v[242:243], v31 offset:4352
    ds_read_b64_tr_b16 v[244:245], v32 offset:4096
    ds_read_b64_tr_b16 v[246:247], v32 offset:4352
L_gu_nowd:
    v_lshlrev_b32 v44, v28, v44
    v_lshlrev_b32 v45, v28, v45
    v_and_b32 v44, 0xffff0000, v44
    v_and_b32 v45, 0xffff0000, v45
    v_mul_f32 v44, s94, v44
    v_exp_f32 v44, v44
    s_nop 0
    v_add_f32 v44, 1.0, v44
    v_rcp_f32 v44, v44
    s_nop 0
    v_mul_f32 v44, v44, v45
    v_cvt_pk_bf16_f32 v44, v44, v44
    ds_write_b16 v24, v44
    s_waitcnt lgkmcnt(0)
    ds_read_b128 v[48:51], v25
    s_waitcnt lgkmcnt(0)
    v_mfma_f32_16x16x32_bf16 v[52:55], v[48:51], v[240:243], 0
    v_mfma_f32_16x16x32_bf16 v[56:59], v[48:51], v[244:247], 0
    s_mov_b64 exec, 0xffff
    s_nop 5
    ds_write_b32 v26, v52
    ds_write_b32 v26, v56 offset:768
    s_mov_b64 exec, -1
L_p5_bar:
    s_waitcnt lgkmcnt(0)
    s_barrier
    s_cmp_lg_u32 s3, 0
    s_cbranch_scc1 L_p5_done
    ds_read_b128 v[44:47], v27
    ds_read_b128 v[48:51], v27 offset:16
    s_waitcnt lgkmcnt(0)
    v_add_f32 v44, v44, v45
    v_add_f32 v46, v46, v47
    v_add_f32 v48, v48, v49
    v_add_f32 v44, v44, v46
    v_add_f32 v48, v48, v50
    v_add_f32 v44, v44, v48
    s_nop 1
    v_mov_b32_dpp v45, v44 quad_perm:[1,1,3,3] row_mask:0xf bank_mask:0xf
    v_cvt_pk_bf16_f32 v44, v44, v45
    v_min_u32 v44, -2, v44
    s_mov_b32 exec_lo, 0x55555555
    s_mov_b32 exec_hi, 0
    buffer_store_dword v44, v9, s[56:59], s79 offen sc1
    s_mov_b64 exec, -1
    s_waitcnt vmcnt(0)
L_p5_done:
    s_barrier
    s_cmp_lg_u32 s72, 0
    s_cbranch_scc1 L_final
    s_mov_b32 s72, 1
    s_mov_b32 s76, 0x400
    s_mov_b32 s77, 0x200
    s_mov_b32 s78, 0x4000
    s_mov_b32 s79, 0xC000
    s_mov_b32 s80, 0x4000
    s_mov_b32 s62, 23552
    s_waitcnt lgkmcnt(0)
    s_branch L_layer
L_final:
    s_cmp_lg_u32 s4, 0
    s_cbranch_scc1 L_fin_stamps
    s_lshr_b32 s84, s7, 1
    s_cmp_lg_u32 s3, s84
    s_cbranch_scc1 L_fin_stamps
    buffer_load_dwordx4 v[68:71], v8, s[56:59], s79 offen sc1
    s_waitcnt vmcnt(0)
L_pd_c_35:
    v_max3_u32 v84, v68, v69, v70
    v_max_u32 v84, v84, v71
    v_cmp_eq_u32 vcc, -1, v84
    s_cbranch_vccz L_pd_ok_34
    s_add_u32 s81, s81, 1
    s_cmp_lt_u32 s81, 1048576
    s_cbranch_scc1 L_pd_r_33
    s_branch L_bail
L_pd_r_33:
    buffer_load_dwordx4 v[68:71], v8, s[56:59], s79 offen sc1
    s_waitcnt vmcnt(0)
    s_branch L_pd_c_35
L_pd_ok_34:
    v_mfma_f32_16x16x32_bf16 v[72:75], v[68:71], v[248:251], 0
    v_mfma_f32_16x16x32_bf16 v[76:79], v[68:71], v[252:255], 0
    s_nop 6
    v_add_f32 v72, v72, v73
    v_add_f32 v74, v74, v75
    v_add_f32 v76, v76, v77
    v_add_f32 v78, v78, v79
    v_add_f32 v72, v72, v74
    v_add_f32 v76, v76, v78
    s_nop 1
    v_permlane16_swap_b32 v72, v76
    v_add_f32 v72, v72, v76
    v_cvt_pk_bf16_f32 v72, v72, v72
    v_and_b32 v72, 0xffff0000, v72
    v_add_f32 v29, v29, v72
    v_cvt_pk_bf16_f32 v80, v29, v29
    v_and_b32 v29, 0xffff0000, v80
    s_and_b32 s84, s7, 1
    s_cmp_eq_u32 s84, 0
    s_cselect_b32 exec_lo, -1, 0
    s_cselect_b32 exec_hi, 0, -1
    s_lshl_b32 s84, s6, 10
    v_lshl_add_u32 v44, v0, 1, s84
    buffer_store_short v80, v44, s[64:67], 0 offen
    s_mov_b64 exec, -1
    s_cmp_lg_u32 s7, 0
    s_cbranch_scc1 L_fin_stamps
    s_lshl_b32 s84, s6, 7
    s_add_u32 s84, s84, 921600
    v_mov_b32 v46, s84
    v_mov_b32 v45, s60
    s_mov_b64 exec, 1
    buffer_store_dword v45, v46, s[56:59], 0 offen sc1
    s_mov_b64 exec, -1
L_fin_stamps:
    s_branch L_end
L_bail:
L_end:
    s_endpgm

.section .rodata,"a"
.p2align 6
.amdhsa_kernel interleave_layers__sliding_block_cached__glu_gated_glu__decode_kernel
  .amdhsa_next_free_vgpr 256
  .amdhsa_next_free_sgpr 102
  .amdhsa_accum_offset 256
  .amdhsa_group_segment_fixed_size 0
  .amdhsa_kernarg_size 96
  .amdhsa_user_sgpr_count 2
  .amdhsa_user_sgpr_kernarg_segment_ptr 1
  .amdhsa_system_sgpr_workgroup_id_x 1
  .amdhsa_float_denorm_mode_32 3
.end_amdhsa_kernel
```
